```python
import torch

def _softmax(x, axis=-1):
    return torch.softmax(x, dim=axis)
def _gelu(x):
    return torch.nn.functional.gelu(x, approximate="tanh")
def _silu(x):
    return torch.nn.functional.silu(x)
def _sigmoid(x):
    return torch.sigmoid(x)
def _layernorm(x, axis=-1, eps=1e-5):
    m = x.mean(dim=axis, keepdim=True)
    v = x.var(dim=axis, keepdim=True, unbiased=False)
    return (x - m) / torch.sqrt(v + eps)
def _scatter_add(tgt, idx, src, axis=0):
    return tgt.clone().index_add_(axis, idx, src)
def _segment_sum(src, seg, n):
    out = torch.zeros((n,) + src.shape[1:], dtype=src.dtype)
    return out.index_add_(0, seg, src)
def _pad(x, pw):
    flat = tuple(v for pair in reversed(pw) for v in pair)
    return torch.nn.functional.pad(x, flat)

kernel_name = 'standalone__softmax_full_bidir__decode'

def setup_inputs():

    _w = (lambda a: (lambda t: t.to(torch.bfloat16) if t.is_floating_point() else t)(torch.as_tensor(a)))
    B, H, Sq, Skv, Dh = 4, 32, 1, 4096, 128
    return {
        "q": _w((lambda *s: torch.randn(*s, dtype=torch.bfloat16) * 0.8)(B, H, Sq, Dh)),
        "k": _w((lambda *s: torch.randn(*s, dtype=torch.bfloat16) * 0.8)(B, H, Skv, Dh)),
        "v": _w((lambda *s: torch.randn(*s, dtype=torch.bfloat16) * 0.05)(B, H, Skv, Dh)),
    }

def reference(q, k, v):
    scale = q.shape[-1] ** -0.5
    scores = torch.einsum('bhqd,bhkd->bhqk', q, k) * scale
    attn = _softmax(scores, axis=-1)
    return torch.einsum('bhqk,bhkd->bhqd', attn, v)
```

```asm
; @launch grid=(256,1,1) block=(512,1,1) lds=8192
.amdgcn_target "amdgcn-amd-amdhsa--gfx950"
.text
.globl standalone__softmax_full_bidir__decode_kernel
.p2align 8
.type standalone__softmax_full_bidir__decode_kernel,@function
standalone__softmax_full_bidir__decode_kernel:
    s_cmp_ge_u32 s2, 256
    s_cbranch_scc1 L_end
    s_load_dwordx4 s[4:7], s[0:1], 0
    s_load_dwordx4 s[8:11], s[0:1], 16
    s_load_dwordx4 s[12:15], s[0:1], 32
    v_and_b32 v1, 63, v0
    v_lshrrev_b32 v3, 6, v0
    v_and_b32 v4, 15, v0
    v_readfirstlane_b32 s32, v3
    v_lshlrev_b32 v4, 4, v4
    s_lshr_b32 s37, s2, 1
    s_lshl_b32 s38, s2, 19
    s_lshl_b32 s39, s37, 8
    s_mov_b32 s35, 0x3e0293ee
    s_mov_b32 s36, 0xbe0293ee
    s_lshr_b32 s33, s2, 3
    s_add_u32 s33, s32, s33
    s_and_b32 s33, s33, 7
    s_lshl_b32 s33, s33, 12
    v_lshlrev_b32 v2, 4, v1
    v_add_u32 v2, s33, v2
    s_lshr_b32 s43, s2, 6
    s_lshl_b32 s43, s43, 2
    s_mul_i32 s43, s43, 32768
    s_and_b32 s43, s43, 524287
    s_mov_b32 s33, s43
    s_mov_b32 s42, 0
    s_waitcnt lgkmcnt(0)
    s_mov_b32 s24, s4
    s_and_b32 s25, s5, 0xffff
    s_mov_b32 s26, 32768
    s_mov_b32 s27, 0x00020000
    s_add_u32 s16, s6, s38
    s_addc_u32 s17, s7, 0
    s_and_b32 s17, s17, 0xffff
    s_mov_b32 s18, 524288
    s_mov_b32 s19, 0x00020000
    s_add_u32 s20, s8, s38
    s_addc_u32 s21, s9, 0
    s_and_b32 s21, s21, 0xffff
    s_mov_b32 s22, 524288
    s_mov_b32 s23, 0x00020000
    buffer_load_dwordx4 v[36:39], v2, s[16:19], s33 offen offset:0 nt
    buffer_load_dwordx4 v[40:43], v2, s[16:19], s33 offen offset:1024 nt
    buffer_load_dwordx4 v[44:47], v2, s[16:19], s33 offen offset:2048 nt
    buffer_load_dwordx4 v[48:51], v2, s[16:19], s33 offen offset:3072 nt
    buffer_load_dwordx4 v[52:55], v2, s[20:23], s33 offen offset:0 nt
    buffer_load_dwordx4 v[56:59], v2, s[20:23], s33 offen offset:1024 nt
    buffer_load_dwordx4 v[60:63], v2, s[20:23], s33 offen offset:2048 nt
    buffer_load_dwordx4 v[64:67], v2, s[20:23], s33 offen offset:3072 nt
    s_add_u32 s42, s42, 32768
    s_add_u32 s33, s42, s43
    s_and_b32 s33, s33, 524287
    s_and_b32 s44, s42, 524288
    s_or_b32 s33, s33, s44
    buffer_load_dwordx4 v[8:11], v4, s[24:27], s39 offen
    buffer_load_dwordx4 v[68:71], v2, s[16:19], s33 offen offset:0 nt
    buffer_load_dwordx4 v[72:75], v2, s[16:19], s33 offen offset:1024 nt
    buffer_load_dwordx4 v[76:79], v2, s[16:19], s33 offen offset:2048 nt
    buffer_load_dwordx4 v[80:83], v2, s[16:19], s33 offen offset:3072 nt
    buffer_load_dwordx4 v[84:87], v2, s[20:23], s33 offen offset:0 nt
    buffer_load_dwordx4 v[88:91], v2, s[20:23], s33 offen offset:1024 nt
    buffer_load_dwordx4 v[92:95], v2, s[20:23], s33 offen offset:2048 nt
    buffer_load_dwordx4 v[96:99], v2, s[20:23], s33 offen offset:3072 nt
    s_add_u32 s42, s42, 32768
    s_add_u32 s33, s42, s43
    s_and_b32 s33, s33, 524287
    s_and_b32 s44, s42, 524288
    s_or_b32 s33, s33, s44
    buffer_load_dwordx4 v[100:103], v2, s[16:19], s33 offen offset:0 nt
    buffer_load_dwordx4 v[104:107], v2, s[16:19], s33 offen offset:1024 nt
    buffer_load_dwordx4 v[108:111], v2, s[16:19], s33 offen offset:2048 nt
    buffer_load_dwordx4 v[112:115], v2, s[16:19], s33 offen offset:3072 nt
    buffer_load_dwordx4 v[116:119], v2, s[20:23], s33 offen offset:0 nt
    buffer_load_dwordx4 v[120:123], v2, s[20:23], s33 offen offset:1024 nt
    buffer_load_dwordx4 v[124:127], v2, s[20:23], s33 offen offset:2048 nt
    buffer_load_dwordx4 v[128:131], v2, s[20:23], s33 offen offset:3072 nt
    s_add_u32 s42, s42, 32768
    s_add_u32 s33, s42, s43
    s_and_b32 s33, s33, 524287
    s_and_b32 s44, s42, 524288
    s_or_b32 s33, s33, s44
    buffer_load_dwordx4 v[132:135], v2, s[16:19], s33 offen offset:0 nt
    buffer_load_dwordx4 v[136:139], v2, s[16:19], s33 offen offset:1024 nt
    buffer_load_dwordx4 v[140:143], v2, s[16:19], s33 offen offset:2048 nt
    buffer_load_dwordx4 v[144:147], v2, s[16:19], s33 offen offset:3072 nt
    buffer_load_dwordx4 v[148:151], v2, s[20:23], s33 offen offset:0 nt
    buffer_load_dwordx4 v[152:155], v2, s[20:23], s33 offen offset:1024 nt
    buffer_load_dwordx4 v[156:159], v2, s[20:23], s33 offen offset:2048 nt
    buffer_load_dwordx4 v[160:163], v2, s[20:23], s33 offen offset:3072 nt
    s_add_u32 s42, s42, 32768
    s_add_u32 s33, s42, s43
    s_and_b32 s33, s33, 524287
    s_and_b32 s44, s42, 524288
    s_or_b32 s33, s33, s44
    v_mov_b32 v20, 0xff800000
    v_mov_b32 v21, 0
    v_mov_b32 v24, 0
    v_mov_b32 v25, 0
    v_mov_b32 v26, 0
    v_mov_b32 v27, 0
    v_mov_b32 v28, 0
    v_mov_b32 v29, 0
    v_mov_b32 v30, 0
    v_mov_b32 v31, 0
    s_mov_b32 s34, 4
    s_waitcnt vmcnt(24)
L_loop:
    s_waitcnt vmcnt(28)
    v_dot2_f32_bf16 v12, v36, v8, 0
    v_dot2_f32_bf16 v13, v40, v8, 0
    v_dot2_f32_bf16 v14, v44, v8, 0
    v_dot2_f32_bf16 v15, v48, v8, 0
    v_dot2_f32_bf16 v12, v37, v9, v12
    v_dot2_f32_bf16 v13, v41, v9, v13
    v_dot2_f32_bf16 v14, v45, v9, v14
    v_dot2_f32_bf16 v15, v49, v9, v15
    v_dot2_f32_bf16 v12, v38, v10, v12
    v_dot2_f32_bf16 v13, v42, v10, v13
    v_dot2_f32_bf16 v14, v46, v10, v14
    v_dot2_f32_bf16 v15, v50, v10, v15
    v_dot2_f32_bf16 v12, v39, v11, v12
    v_dot2_f32_bf16 v13, v43, v11, v13
    v_dot2_f32_bf16 v14, v47, v11, v14
    v_dot2_f32_bf16 v15, v51, v11, v15
    buffer_load_dwordx4 v[36:39], v2, s[16:19], s33 offen offset:0 nt
    buffer_load_dwordx4 v[40:43], v2, s[16:19], s33 offen offset:1024 nt
    buffer_load_dwordx4 v[44:47], v2, s[16:19], s33 offen offset:2048 nt
    buffer_load_dwordx4 v[48:51], v2, s[16:19], s33 offen offset:3072 nt
    v_add_f32_dpp v12, v12, v12 quad_perm:[1,0,3,2] row_mask:0xf bank_mask:0xf
    v_add_f32_dpp v13, v13, v13 quad_perm:[1,0,3,2] row_mask:0xf bank_mask:0xf
    v_add_f32_dpp v14, v14, v14 quad_perm:[1,0,3,2] row_mask:0xf bank_mask:0xf
    v_add_f32_dpp v15, v15, v15 quad_perm:[1,0,3,2] row_mask:0xf bank_mask:0xf
    v_add_f32_dpp v12, v12, v12 quad_perm:[2,3,0,1] row_mask:0xf bank_mask:0xf
    v_add_f32_dpp v13, v13, v13 quad_perm:[2,3,0,1] row_mask:0xf bank_mask:0xf
    v_add_f32_dpp v14, v14, v14 quad_perm:[2,3,0,1] row_mask:0xf bank_mask:0xf
    v_add_f32_dpp v15, v15, v15 quad_perm:[2,3,0,1] row_mask:0xf bank_mask:0xf
    v_add_f32_dpp v12, v12, v12 row_half_mirror row_mask:0xf bank_mask:0xf
    v_add_f32_dpp v13, v13, v13 row_half_mirror row_mask:0xf bank_mask:0xf
    v_add_f32_dpp v14, v14, v14 row_half_mirror row_mask:0xf bank_mask:0xf
    v_add_f32_dpp v15, v15, v15 row_half_mirror row_mask:0xf bank_mask:0xf
    v_add_f32_dpp v12, v12, v12 row_mirror row_mask:0xf bank_mask:0xf
    v_add_f32_dpp v13, v13, v13 row_mirror row_mask:0xf bank_mask:0xf
    v_add_f32_dpp v14, v14, v14 row_mirror row_mask:0xf bank_mask:0xf
    v_add_f32_dpp v15, v15, v15 row_mirror row_mask:0xf bank_mask:0xf
    v_max3_f32 v22, v12, v13, v20
    v_max3_f32 v22, v14, v15, v22
    v_mul_f32 v3, s36, v22
    v_fma_f32 v23, v20, s35, v3
    v_fma_f32 v16, v12, s35, v3
    v_fma_f32 v17, v13, s35, v3
    v_fma_f32 v18, v14, s35, v3
    v_fma_f32 v19, v15, s35, v3
    v_exp_f32 v23, v23
    v_exp_f32 v16, v16
    v_exp_f32 v17, v17
    v_exp_f32 v18, v18
    v_exp_f32 v19, v19
    v_mov_b32 v20, v22
    v_fma_f32 v21, v21, v23, v16
    v_mul_f32 v24, v24, v23
    v_mul_f32 v25, v25, v23
    v_mul_f32 v26, v26, v23
    v_mul_f32 v27, v27, v23
    v_mul_f32 v28, v28, v23
    v_mul_f32 v29, v29, v23
    v_mul_f32 v30, v30, v23
    v_mul_f32 v31, v31, v23
    v_add_f32 v3, v17, v18
    v_add_f32 v21, v21, v19
    v_add_f32 v21, v21, v3
    s_waitcnt vmcnt(28)
    v_lshlrev_b32 v32, 16, v52
    v_and_b32 v33, 0xffff0000, v52
    v_fmac_f32 v24, v16, v32
    v_fmac_f32 v25, v16, v33
    v_lshlrev_b32 v34, 16, v53
    v_and_b32 v35, 0xffff0000, v53
    v_fmac_f32 v26, v16, v34
    v_fmac_f32 v27, v16, v35
    v_lshlrev_b32 v32, 16, v54
    v_and_b32 v33, 0xffff0000, v54
    v_fmac_f32 v28, v16, v32
    v_fmac_f32 v29, v16, v33
    v_lshlrev_b32 v34, 16, v55
    v_and_b32 v35, 0xffff0000, v55
    v_fmac_f32 v30, v16, v34
    v_fmac_f32 v31, v16, v35
    v_lshlrev_b32 v32, 16, v56
    v_and_b32 v33, 0xffff0000, v56
    v_fmac_f32 v24, v17, v32
    v_fmac_f32 v25, v17, v33
    v_lshlrev_b32 v34, 16, v57
    v_and_b32 v35, 0xffff0000, v57
    v_fmac_f32 v26, v17, v34
    v_fmac_f32 v27, v17, v35
    v_lshlrev_b32 v32, 16, v58
    v_and_b32 v33, 0xffff0000, v58
    v_fmac_f32 v28, v17, v32
    v_fmac_f32 v29, v17, v33
    v_lshlrev_b32 v34, 16, v59
    v_and_b32 v35, 0xffff0000, v59
    v_fmac_f32 v30, v17, v34
    v_fmac_f32 v31, v17, v35
    v_lshlrev_b32 v32, 16, v60
    v_and_b32 v33, 0xffff0000, v60
    v_fmac_f32 v24, v18, v32
    v_fmac_f32 v25, v18, v33
    v_lshlrev_b32 v34, 16, v61
    v_and_b32 v35, 0xffff0000, v61
    v_fmac_f32 v26, v18, v34
    v_fmac_f32 v27, v18, v35
    v_lshlrev_b32 v32, 16, v62
    v_and_b32 v33, 0xffff0000, v62
    v_fmac_f32 v28, v18, v32
    v_fmac_f32 v29, v18, v33
    v_lshlrev_b32 v34, 16, v63
    v_and_b32 v35, 0xffff0000, v63
    v_fmac_f32 v30, v18, v34
    v_fmac_f32 v31, v18, v35
    v_lshlrev_b32 v32, 16, v64
    v_and_b32 v33, 0xffff0000, v64
    v_fmac_f32 v24, v19, v32
    v_fmac_f32 v25, v19, v33
    v_lshlrev_b32 v34, 16, v65
    v_and_b32 v35, 0xffff0000, v65
    v_fmac_f32 v26, v19, v34
    v_fmac_f32 v27, v19, v35
    v_lshlrev_b32 v32, 16, v66
    v_and_b32 v33, 0xffff0000, v66
    v_fmac_f32 v28, v19, v32
    v_fmac_f32 v29, v19, v33
    v_lshlrev_b32 v34, 16, v67
    v_and_b32 v35, 0xffff0000, v67
    v_fmac_f32 v30, v19, v34
    v_fmac_f32 v31, v19, v35
    buffer_load_dwordx4 v[52:55], v2, s[20:23], s33 offen offset:0 nt
    buffer_load_dwordx4 v[56:59], v2, s[20:23], s33 offen offset:1024 nt
    buffer_load_dwordx4 v[60:63], v2, s[20:23], s33 offen offset:2048 nt
    buffer_load_dwordx4 v[64:67], v2, s[20:23], s33 offen offset:3072 nt
    s_add_u32 s42, s42, 32768
    s_add_u32 s33, s42, s43
    s_and_b32 s33, s33, 524287
    s_and_b32 s44, s42, 524288
    s_or_b32 s33, s33, s44
    s_waitcnt vmcnt(28)
    v_dot2_f32_bf16 v12, v68, v8, 0
    v_dot2_f32_bf16 v13, v72, v8, 0
    v_dot2_f32_bf16 v14, v76, v8, 0
    v_dot2_f32_bf16 v15, v80, v8, 0
    v_dot2_f32_bf16 v12, v69, v9, v12
    v_dot2_f32_bf16 v13, v73, v9, v13
    v_dot2_f32_bf16 v14, v77, v9, v14
    v_dot2_f32_bf16 v15, v81, v9, v15
    v_dot2_f32_bf16 v12, v70, v10, v12
    v_dot2_f32_bf16 v13, v74, v10, v13
    v_dot2_f32_bf16 v14, v78, v10, v14
    v_dot2_f32_bf16 v15, v82, v10, v15
    v_dot2_f32_bf16 v12, v71, v11, v12
    v_dot2_f32_bf16 v13, v75, v11, v13
    v_dot2_f32_bf16 v14, v79, v11, v14
    v_dot2_f32_bf16 v15, v83, v11, v15
    buffer_load_dwordx4 v[68:71], v2, s[16:19], s33 offen offset:0 nt
    buffer_load_dwordx4 v[72:75], v2, s[16:19], s33 offen offset:1024 nt
    buffer_load_dwordx4 v[76:79], v2, s[16:19], s33 offen offset:2048 nt
    buffer_load_dwordx4 v[80:83], v2, s[16:19], s33 offen offset:3072 nt
    v_add_f32_dpp v12, v12, v12 quad_perm:[1,0,3,2] row_mask:0xf bank_mask:0xf
    v_add_f32_dpp v13, v13, v13 quad_perm:[1,0,3,2] row_mask:0xf bank_mask:0xf
    v_add_f32_dpp v14, v14, v14 quad_perm:[1,0,3,2] row_mask:0xf bank_mask:0xf
    v_add_f32_dpp v15, v15, v15 quad_perm:[1,0,3,2] row_mask:0xf bank_mask:0xf
    v_add_f32_dpp v12, v12, v12 quad_perm:[2,3,0,1] row_mask:0xf bank_mask:0xf
    v_add_f32_dpp v13, v13, v13 quad_perm:[2,3,0,1] row_mask:0xf bank_mask:0xf
    v_add_f32_dpp v14, v14, v14 quad_perm:[2,3,0,1] row_mask:0xf bank_mask:0xf
    v_add_f32_dpp v15, v15, v15 quad_perm:[2,3,0,1] row_mask:0xf bank_mask:0xf
    v_add_f32_dpp v12, v12, v12 row_half_mirror row_mask:0xf bank_mask:0xf
    v_add_f32_dpp v13, v13, v13 row_half_mirror row_mask:0xf bank_mask:0xf
    v_add_f32_dpp v14, v14, v14 row_half_mirror row_mask:0xf bank_mask:0xf
    v_add_f32_dpp v15, v15, v15 row_half_mirror row_mask:0xf bank_mask:0xf
    v_add_f32_dpp v12, v12, v12 row_mirror row_mask:0xf bank_mask:0xf
    v_add_f32_dpp v13, v13, v13 row_mirror row_mask:0xf bank_mask:0xf
    v_add_f32_dpp v14, v14, v14 row_mirror row_mask:0xf bank_mask:0xf
    v_add_f32_dpp v15, v15, v15 row_mirror row_mask:0xf bank_mask:0xf
    v_max3_f32 v22, v12, v13, v20
    v_max3_f32 v22, v14, v15, v22
    v_mul_f32 v3, s36, v22
    v_fma_f32 v23, v20, s35, v3
    v_fma_f32 v16, v12, s35, v3
    v_fma_f32 v17, v13, s35, v3
    v_fma_f32 v18, v14, s35, v3
    v_fma_f32 v19, v15, s35, v3
    v_exp_f32 v23, v23
    v_exp_f32 v16, v16
    v_exp_f32 v17, v17
    v_exp_f32 v18, v18
    v_exp_f32 v19, v19
    v_mov_b32 v20, v22
    v_fma_f32 v21, v21, v23, v16
    v_mul_f32 v24, v24, v23
    v_mul_f32 v25, v25, v23
    v_mul_f32 v26, v26, v23
    v_mul_f32 v27, v27, v23
    v_mul_f32 v28, v28, v23
    v_mul_f32 v29, v29, v23
    v_mul_f32 v30, v30, v23
    v_mul_f32 v31, v31, v23
    v_add_f32 v3, v17, v18
    v_add_f32 v21, v21, v19
    v_add_f32 v21, v21, v3
    s_waitcnt vmcnt(28)
    v_lshlrev_b32 v32, 16, v84
    v_and_b32 v33, 0xffff0000, v84
    v_fmac_f32 v24, v16, v32
    v_fmac_f32 v25, v16, v33
    v_lshlrev_b32 v34, 16, v85
    v_and_b32 v35, 0xffff0000, v85
    v_fmac_f32 v26, v16, v34
    v_fmac_f32 v27, v16, v35
    v_lshlrev_b32 v32, 16, v86
    v_and_b32 v33, 0xffff0000, v86
    v_fmac_f32 v28, v16, v32
    v_fmac_f32 v29, v16, v33
    v_lshlrev_b32 v34, 16, v87
    v_and_b32 v35, 0xffff0000, v87
    v_fmac_f32 v30, v16, v34
    v_fmac_f32 v31, v16, v35
    v_lshlrev_b32 v32, 16, v88
    v_and_b32 v33, 0xffff0000, v88
    v_fmac_f32 v24, v17, v32
    v_fmac_f32 v25, v17, v33
    v_lshlrev_b32 v34, 16, v89
    v_and_b32 v35, 0xffff0000, v89
    v_fmac_f32 v26, v17, v34
    v_fmac_f32 v27, v17, v35
    v_lshlrev_b32 v32, 16, v90
    v_and_b32 v33, 0xffff0000, v90
    v_fmac_f32 v28, v17, v32
    v_fmac_f32 v29, v17, v33
    v_lshlrev_b32 v34, 16, v91
    v_and_b32 v35, 0xffff0000, v91
    v_fmac_f32 v30, v17, v34
    v_fmac_f32 v31, v17, v35
    v_lshlrev_b32 v32, 16, v92
    v_and_b32 v33, 0xffff0000, v92
    v_fmac_f32 v24, v18, v32
    v_fmac_f32 v25, v18, v33
    v_lshlrev_b32 v34, 16, v93
    v_and_b32 v35, 0xffff0000, v93
    v_fmac_f32 v26, v18, v34
    v_fmac_f32 v27, v18, v35
    v_lshlrev_b32 v32, 16, v94
    v_and_b32 v33, 0xffff0000, v94
    v_fmac_f32 v28, v18, v32
    v_fmac_f32 v29, v18, v33
    v_lshlrev_b32 v34, 16, v95
    v_and_b32 v35, 0xffff0000, v95
    v_fmac_f32 v30, v18, v34
    v_fmac_f32 v31, v18, v35
    v_lshlrev_b32 v32, 16, v96
    v_and_b32 v33, 0xffff0000, v96
    v_fmac_f32 v24, v19, v32
    v_fmac_f32 v25, v19, v33
    v_lshlrev_b32 v34, 16, v97
    v_and_b32 v35, 0xffff0000, v97
    v_fmac_f32 v26, v19, v34
    v_fmac_f32 v27, v19, v35
    v_lshlrev_b32 v32, 16, v98
    v_and_b32 v33, 0xffff0000, v98
    v_fmac_f32 v28, v19, v32
    v_fmac_f32 v29, v19, v33
    v_lshlrev_b32 v34, 16, v99
    v_and_b32 v35, 0xffff0000, v99
    v_fmac_f32 v30, v19, v34
    v_fmac_f32 v31, v19, v35
    buffer_load_dwordx4 v[84:87], v2, s[20:23], s33 offen offset:0 nt
    buffer_load_dwordx4 v[88:91], v2, s[20:23], s33 offen offset:1024 nt
    buffer_load_dwordx4 v[92:95], v2, s[20:23], s33 offen offset:2048 nt
    buffer_load_dwordx4 v[96:99], v2, s[20:23], s33 offen offset:3072 nt
    s_add_u32 s42, s42, 32768
    s_add_u32 s33, s42, s43
    s_and_b32 s33, s33, 524287
    s_and_b32 s44, s42, 524288
    s_or_b32 s33, s33, s44
    s_waitcnt vmcnt(28)
    v_dot2_f32_bf16 v12, v100, v8, 0
    v_dot2_f32_bf16 v13, v104, v8, 0
    v_dot2_f32_bf16 v14, v108, v8, 0
    v_dot2_f32_bf16 v15, v112, v8, 0
    v_dot2_f32_bf16 v12, v101, v9, v12
    v_dot2_f32_bf16 v13, v105, v9, v13
    v_dot2_f32_bf16 v14, v109, v9, v14
    v_dot2_f32_bf16 v15, v113, v9, v15
    v_dot2_f32_bf16 v12, v102, v10, v12
    v_dot2_f32_bf16 v13, v106, v10, v13
    v_dot2_f32_bf16 v14, v110, v10, v14
    v_dot2_f32_bf16 v15, v114, v10, v15
    v_dot2_f32_bf16 v12, v103, v11, v12
    v_dot2_f32_bf16 v13, v107, v11, v13
    v_dot2_f32_bf16 v14, v111, v11, v14
    v_dot2_f32_bf16 v15, v115, v11, v15
    buffer_load_dwordx4 v[100:103], v2, s[16:19], s33 offen offset:0 nt
    buffer_load_dwordx4 v[104:107], v2, s[16:19], s33 offen offset:1024 nt
    buffer_load_dwordx4 v[108:111], v2, s[16:19], s33 offen offset:2048 nt
    buffer_load_dwordx4 v[112:115], v2, s[16:19], s33 offen offset:3072 nt
    v_add_f32_dpp v12, v12, v12 quad_perm:[1,0,3,2] row_mask:0xf bank_mask:0xf
    v_add_f32_dpp v13, v13, v13 quad_perm:[1,0,3,2] row_mask:0xf bank_mask:0xf
    v_add_f32_dpp v14, v14, v14 quad_perm:[1,0,3,2] row_mask:0xf bank_mask:0xf
    v_add_f32_dpp v15, v15, v15 quad_perm:[1,0,3,2] row_mask:0xf bank_mask:0xf
    v_add_f32_dpp v12, v12, v12 quad_perm:[2,3,0,1] row_mask:0xf bank_mask:0xf
    v_add_f32_dpp v13, v13, v13 quad_perm:[2,3,0,1] row_mask:0xf bank_mask:0xf
    v_add_f32_dpp v14, v14, v14 quad_perm:[2,3,0,1] row_mask:0xf bank_mask:0xf
    v_add_f32_dpp v15, v15, v15 quad_perm:[2,3,0,1] row_mask:0xf bank_mask:0xf
    v_add_f32_dpp v12, v12, v12 row_half_mirror row_mask:0xf bank_mask:0xf
    v_add_f32_dpp v13, v13, v13 row_half_mirror row_mask:0xf bank_mask:0xf
    v_add_f32_dpp v14, v14, v14 row_half_mirror row_mask:0xf bank_mask:0xf
    v_add_f32_dpp v15, v15, v15 row_half_mirror row_mask:0xf bank_mask:0xf
    v_add_f32_dpp v12, v12, v12 row_mirror row_mask:0xf bank_mask:0xf
    v_add_f32_dpp v13, v13, v13 row_mirror row_mask:0xf bank_mask:0xf
    v_add_f32_dpp v14, v14, v14 row_mirror row_mask:0xf bank_mask:0xf
    v_add_f32_dpp v15, v15, v15 row_mirror row_mask:0xf bank_mask:0xf
    v_max3_f32 v22, v12, v13, v20
    v_max3_f32 v22, v14, v15, v22
    v_mul_f32 v3, s36, v22
    v_fma_f32 v23, v20, s35, v3
    v_fma_f32 v16, v12, s35, v3
    v_fma_f32 v17, v13, s35, v3
    v_fma_f32 v18, v14, s35, v3
    v_fma_f32 v19, v15, s35, v3
    v_exp_f32 v23, v23
    v_exp_f32 v16, v16
    v_exp_f32 v17, v17
    v_exp_f32 v18, v18
    v_exp_f32 v19, v19
    v_mov_b32 v20, v22
    v_fma_f32 v21, v21, v23, v16
    v_mul_f32 v24, v24, v23
    v_mul_f32 v25, v25, v23
    v_mul_f32 v26, v26, v23
    v_mul_f32 v27, v27, v23
    v_mul_f32 v28, v28, v23
    v_mul_f32 v29, v29, v23
    v_mul_f32 v30, v30, v23
    v_mul_f32 v31, v31, v23
    v_add_f32 v3, v17, v18
    v_add_f32 v21, v21, v19
    v_add_f32 v21, v21, v3
    s_waitcnt vmcnt(28)
    v_lshlrev_b32 v32, 16, v116
    v_and_b32 v33, 0xffff0000, v116
    v_fmac_f32 v24, v16, v32
    v_fmac_f32 v25, v16, v33
    v_lshlrev_b32 v34, 16, v117
    v_and_b32 v35, 0xffff0000, v117
    v_fmac_f32 v26, v16, v34
    v_fmac_f32 v27, v16, v35
    v_lshlrev_b32 v32, 16, v118
    v_and_b32 v33, 0xffff0000, v118
    v_fmac_f32 v28, v16, v32
    v_fmac_f32 v29, v16, v33
    v_lshlrev_b32 v34, 16, v119
    v_and_b32 v35, 0xffff0000, v119
    v_fmac_f32 v30, v16, v34
    v_fmac_f32 v31, v16, v35
    v_lshlrev_b32 v32, 16, v120
    v_and_b32 v33, 0xffff0000, v120
    v_fmac_f32 v24, v17, v32
    v_fmac_f32 v25, v17, v33
    v_lshlrev_b32 v34, 16, v121
    v_and_b32 v35, 0xffff0000, v121
    v_fmac_f32 v26, v17, v34
    v_fmac_f32 v27, v17, v35
    v_lshlrev_b32 v32, 16, v122
    v_and_b32 v33, 0xffff0000, v122
    v_fmac_f32 v28, v17, v32
    v_fmac_f32 v29, v17, v33
    v_lshlrev_b32 v34, 16, v123
    v_and_b32 v35, 0xffff0000, v123
    v_fmac_f32 v30, v17, v34
    v_fmac_f32 v31, v17, v35
    v_lshlrev_b32 v32, 16, v124
    v_and_b32 v33, 0xffff0000, v124
    v_fmac_f32 v24, v18, v32
    v_fmac_f32 v25, v18, v33
    v_lshlrev_b32 v34, 16, v125
    v_and_b32 v35, 0xffff0000, v125
    v_fmac_f32 v26, v18, v34
    v_fmac_f32 v27, v18, v35
    v_lshlrev_b32 v32, 16, v126
    v_and_b32 v33, 0xffff0000, v126
    v_fmac_f32 v28, v18, v32
    v_fmac_f32 v29, v18, v33
    v_lshlrev_b32 v34, 16, v127
    v_and_b32 v35, 0xffff0000, v127
    v_fmac_f32 v30, v18, v34
    v_fmac_f32 v31, v18, v35
    v_lshlrev_b32 v32, 16, v128
    v_and_b32 v33, 0xffff0000, v128
    v_fmac_f32 v24, v19, v32
    v_fmac_f32 v25, v19, v33
    v_lshlrev_b32 v34, 16, v129
    v_and_b32 v35, 0xffff0000, v129
    v_fmac_f32 v26, v19, v34
    v_fmac_f32 v27, v19, v35
    v_lshlrev_b32 v32, 16, v130
    v_and_b32 v33, 0xffff0000, v130
    v_fmac_f32 v28, v19, v32
    v_fmac_f32 v29, v19, v33
    v_lshlrev_b32 v34, 16, v131
    v_and_b32 v35, 0xffff0000, v131
    v_fmac_f32 v30, v19, v34
    v_fmac_f32 v31, v19, v35
    buffer_load_dwordx4 v[116:119], v2, s[20:23], s33 offen offset:0 nt
    buffer_load_dwordx4 v[120:123], v2, s[20:23], s33 offen offset:1024 nt
    buffer_load_dwordx4 v[124:127], v2, s[20:23], s33 offen offset:2048 nt
    buffer_load_dwordx4 v[128:131], v2, s[20:23], s33 offen offset:3072 nt
    s_add_u32 s42, s42, 32768
    s_add_u32 s33, s42, s43
    s_and_b32 s33, s33, 524287
    s_and_b32 s44, s42, 524288
    s_or_b32 s33, s33, s44
    s_waitcnt vmcnt(28)
    v_dot2_f32_bf16 v12, v132, v8, 0
    v_dot2_f32_bf16 v13, v136, v8, 0
    v_dot2_f32_bf16 v14, v140, v8, 0
    v_dot2_f32_bf16 v15, v144, v8, 0
    v_dot2_f32_bf16 v12, v133, v9, v12
    v_dot2_f32_bf16 v13, v137, v9, v13
    v_dot2_f32_bf16 v14, v141, v9, v14
    v_dot2_f32_bf16 v15, v145, v9, v15
    v_dot2_f32_bf16 v12, v134, v10, v12
    v_dot2_f32_bf16 v13, v138, v10, v13
    v_dot2_f32_bf16 v14, v142, v10, v14
    v_dot2_f32_bf16 v15, v146, v10, v15
    v_dot2_f32_bf16 v12, v135, v11, v12
    v_dot2_f32_bf16 v13, v139, v11, v13
    v_dot2_f32_bf16 v14, v143, v11, v14
    v_dot2_f32_bf16 v15, v147, v11, v15
    buffer_load_dwordx4 v[132:135], v2, s[16:19], s33 offen offset:0 nt
    buffer_load_dwordx4 v[136:139], v2, s[16:19], s33 offen offset:1024 nt
    buffer_load_dwordx4 v[140:143], v2, s[16:19], s33 offen offset:2048 nt
    buffer_load_dwordx4 v[144:147], v2, s[16:19], s33 offen offset:3072 nt
    v_add_f32_dpp v12, v12, v12 quad_perm:[1,0,3,2] row_mask:0xf bank_mask:0xf
    v_add_f32_dpp v13, v13, v13 quad_perm:[1,0,3,2] row_mask:0xf bank_mask:0xf
    v_add_f32_dpp v14, v14, v14 quad_perm:[1,0,3,2] row_mask:0xf bank_mask:0xf
    v_add_f32_dpp v15, v15, v15 quad_perm:[1,0,3,2] row_mask:0xf bank_mask:0xf
    v_add_f32_dpp v12, v12, v12 quad_perm:[2,3,0,1] row_mask:0xf bank_mask:0xf
    v_add_f32_dpp v13, v13, v13 quad_perm:[2,3,0,1] row_mask:0xf bank_mask:0xf
    v_add_f32_dpp v14, v14, v14 quad_perm:[2,3,0,1] row_mask:0xf bank_mask:0xf
    v_add_f32_dpp v15, v15, v15 quad_perm:[2,3,0,1] row_mask:0xf bank_mask:0xf
    v_add_f32_dpp v12, v12, v12 row_half_mirror row_mask:0xf bank_mask:0xf
    v_add_f32_dpp v13, v13, v13 row_half_mirror row_mask:0xf bank_mask:0xf
    v_add_f32_dpp v14, v14, v14 row_half_mirror row_mask:0xf bank_mask:0xf
    v_add_f32_dpp v15, v15, v15 row_half_mirror row_mask:0xf bank_mask:0xf
    v_add_f32_dpp v12, v12, v12 row_mirror row_mask:0xf bank_mask:0xf
    v_add_f32_dpp v13, v13, v13 row_mirror row_mask:0xf bank_mask:0xf
    v_add_f32_dpp v14, v14, v14 row_mirror row_mask:0xf bank_mask:0xf
    v_add_f32_dpp v15, v15, v15 row_mirror row_mask:0xf bank_mask:0xf
    v_max3_f32 v22, v12, v13, v20
    v_max3_f32 v22, v14, v15, v22
    v_mul_f32 v3, s36, v22
    v_fma_f32 v23, v20, s35, v3
    v_fma_f32 v16, v12, s35, v3
    v_fma_f32 v17, v13, s35, v3
    v_fma_f32 v18, v14, s35, v3
    v_fma_f32 v19, v15, s35, v3
    v_exp_f32 v23, v23
    v_exp_f32 v16, v16
    v_exp_f32 v17, v17
    v_exp_f32 v18, v18
    v_exp_f32 v19, v19
    v_mov_b32 v20, v22
    v_fma_f32 v21, v21, v23, v16
    v_mul_f32 v24, v24, v23
    v_mul_f32 v25, v25, v23
    v_mul_f32 v26, v26, v23
    v_mul_f32 v27, v27, v23
    v_mul_f32 v28, v28, v23
    v_mul_f32 v29, v29, v23
    v_mul_f32 v30, v30, v23
    v_mul_f32 v31, v31, v23
    v_add_f32 v3, v17, v18
    v_add_f32 v21, v21, v19
    v_add_f32 v21, v21, v3
    s_waitcnt vmcnt(28)
    v_lshlrev_b32 v32, 16, v148
    v_and_b32 v33, 0xffff0000, v148
    v_fmac_f32 v24, v16, v32
    v_fmac_f32 v25, v16, v33
    v_lshlrev_b32 v34, 16, v149
    v_and_b32 v35, 0xffff0000, v149
    v_fmac_f32 v26, v16, v34
    v_fmac_f32 v27, v16, v35
    v_lshlrev_b32 v32, 16, v150
    v_and_b32 v33, 0xffff0000, v150
    v_fmac_f32 v28, v16, v32
    v_fmac_f32 v29, v16, v33
    v_lshlrev_b32 v34, 16, v151
    v_and_b32 v35, 0xffff0000, v151
    v_fmac_f32 v30, v16, v34
    v_fmac_f32 v31, v16, v35
    v_lshlrev_b32 v32, 16, v152
    v_and_b32 v33, 0xffff0000, v152
    v_fmac_f32 v24, v17, v32
    v_fmac_f32 v25, v17, v33
    v_lshlrev_b32 v34, 16, v153
    v_and_b32 v35, 0xffff0000, v153
    v_fmac_f32 v26, v17, v34
    v_fmac_f32 v27, v17, v35
    v_lshlrev_b32 v32, 16, v154
    v_and_b32 v33, 0xffff0000, v154
    v_fmac_f32 v28, v17, v32
    v_fmac_f32 v29, v17, v33
    v_lshlrev_b32 v34, 16, v155
    v_and_b32 v35, 0xffff0000, v155
    v_fmac_f32 v30, v17, v34
    v_fmac_f32 v31, v17, v35
    v_lshlrev_b32 v32, 16, v156
    v_and_b32 v33, 0xffff0000, v156
    v_fmac_f32 v24, v18, v32
    v_fmac_f32 v25, v18, v33
    v_lshlrev_b32 v34, 16, v157
    v_and_b32 v35, 0xffff0000, v157
    v_fmac_f32 v26, v18, v34
    v_fmac_f32 v27, v18, v35
    v_lshlrev_b32 v32, 16, v158
    v_and_b32 v33, 0xffff0000, v158
    v_fmac_f32 v28, v18, v32
    v_fmac_f32 v29, v18, v33
    v_lshlrev_b32 v34, 16, v159
    v_and_b32 v35, 0xffff0000, v159
    v_fmac_f32 v30, v18, v34
    v_fmac_f32 v31, v18, v35
    v_lshlrev_b32 v32, 16, v160
    v_and_b32 v33, 0xffff0000, v160
    v_fmac_f32 v24, v19, v32
    v_fmac_f32 v25, v19, v33
    v_lshlrev_b32 v34, 16, v161
    v_and_b32 v35, 0xffff0000, v161
    v_fmac_f32 v26, v19, v34
    v_fmac_f32 v27, v19, v35
    v_lshlrev_b32 v32, 16, v162
    v_and_b32 v33, 0xffff0000, v162
    v_fmac_f32 v28, v19, v32
    v_fmac_f32 v29, v19, v33
    v_lshlrev_b32 v34, 16, v163
    v_and_b32 v35, 0xffff0000, v163
    v_fmac_f32 v30, v19, v34
    v_fmac_f32 v31, v19, v35
    buffer_load_dwordx4 v[148:151], v2, s[20:23], s33 offen offset:0 nt
    buffer_load_dwordx4 v[152:155], v2, s[20:23], s33 offen offset:1024 nt
    buffer_load_dwordx4 v[156:159], v2, s[20:23], s33 offen offset:2048 nt
    buffer_load_dwordx4 v[160:163], v2, s[20:23], s33 offen offset:3072 nt
    s_add_u32 s42, s42, 32768
    s_add_u32 s33, s42, s43
    s_and_b32 s33, s33, 524287
    s_and_b32 s44, s42, 524288
    s_or_b32 s33, s33, s44
    s_sub_u32 s34, s34, 1
    s_cmp_lg_u32 s34, 0
    s_cbranch_scc1 L_loop
    v_mov_b32 v3, v20
    v_mov_b32 v22, v20
    s_nop 1
    v_permlane32_swap_b32 v3, v22
    s_nop 1
    v_max_f32 v22, v3, v22
    v_mov_b32 v3, v22
    s_nop 1
    v_permlane16_swap_b32 v3, v22
    s_nop 1
    v_max_f32 v22, v3, v22
    v_sub_f32 v3, v20, v22
    v_mul_f32 v3, s35, v3
    v_exp_f32 v23, v3
    s_nop 0
    v_mul_f32 v21, v21, v23
    v_mul_f32 v24, v24, v23
    v_mul_f32 v25, v25, v23
    v_mul_f32 v26, v26, v23
    v_mul_f32 v27, v27, v23
    v_mul_f32 v28, v28, v23
    v_mul_f32 v29, v29, v23
    v_mul_f32 v30, v30, v23
    v_mul_f32 v31, v31, v23
    v_mov_b32 v3, v21
    s_nop 1
    v_permlane32_swap_b32 v3, v21
    v_permlane32_swap_b32 v24, v28
    v_permlane32_swap_b32 v25, v29
    v_permlane32_swap_b32 v26, v30
    v_permlane32_swap_b32 v27, v31
    s_nop 1
    v_add_f32 v21, v3, v21
    v_add_f32 v24, v24, v28
    v_add_f32 v25, v25, v29
    v_add_f32 v26, v26, v30
    v_add_f32 v27, v27, v31
    v_mov_b32 v3, v21
    s_nop 1
    v_permlane16_swap_b32 v3, v21
    v_permlane16_swap_b32 v24, v26
    v_permlane16_swap_b32 v25, v27
    s_nop 1
    v_add_f32 v16, v24, v26
    v_add_f32 v17, v25, v27
    v_mov_b32 v18, v22
    v_add_f32 v19, v3, v21
    v_lshlrev_b32 v4, 4, v0
    ds_write_b128 v4, v[16:19]
    s_waitcnt vmcnt(0) lgkmcnt(0)
    s_barrier
    s_cmp_lg_u32 s32, 0
    s_cbranch_scc1 L_end
    ds_read_b128 v[36:39], v4 offset:0
    ds_read_b128 v[40:43], v4 offset:1024
    ds_read_b128 v[44:47], v4 offset:2048
    ds_read_b128 v[48:51], v4 offset:3072
    ds_read_b128 v[52:55], v4 offset:4096
    ds_read_b128 v[56:59], v4 offset:5120
    ds_read_b128 v[60:63], v4 offset:6144
    ds_read_b128 v[64:67], v4 offset:7168
    s_waitcnt lgkmcnt(0)
    v_max_f32 v22, v38, v42
    v_max3_f32 v22, v46, v50, v22
    v_max3_f32 v22, v54, v58, v22
    v_max3_f32 v22, v62, v66, v22
    v_mul_f32 v3, s36, v22
    v_fma_f32 v38, v38, s35, v3
    v_fma_f32 v42, v42, s35, v3
    v_fma_f32 v46, v46, s35, v3
    v_fma_f32 v50, v50, s35, v3
    v_fma_f32 v54, v54, s35, v3
    v_fma_f32 v58, v58, s35, v3
    v_fma_f32 v62, v62, s35, v3
    v_fma_f32 v66, v66, s35, v3
    v_exp_f32 v38, v38
    v_exp_f32 v42, v42
    v_exp_f32 v46, v46
    v_exp_f32 v50, v50
    v_exp_f32 v54, v54
    v_exp_f32 v58, v58
    v_exp_f32 v62, v62
    v_exp_f32 v66, v66
    s_nop 0
    v_mul_f32 v16, v36, v38
    v_mul_f32 v17, v37, v38
    v_mul_f32 v19, v39, v38
    v_fmac_f32 v16, v40, v42
    v_fmac_f32 v17, v41, v42
    v_fmac_f32 v19, v43, v42
    v_fmac_f32 v16, v44, v46
    v_fmac_f32 v17, v45, v46
    v_fmac_f32 v19, v47, v46
    v_fmac_f32 v16, v48, v50
    v_fmac_f32 v17, v49, v50
    v_fmac_f32 v19, v51, v50
    v_fmac_f32 v16, v52, v54
    v_fmac_f32 v17, v53, v54
    v_fmac_f32 v19, v55, v54
    v_fmac_f32 v16, v56, v58
    v_fmac_f32 v17, v57, v58
    v_fmac_f32 v19, v59, v58
    v_fmac_f32 v16, v60, v62
    v_fmac_f32 v17, v61, v62
    v_fmac_f32 v19, v63, v62
    v_fmac_f32 v16, v64, v66
    v_fmac_f32 v17, v65, v66
    v_fmac_f32 v19, v67, v66
    v_mov_b32 v18, v22
    s_mov_b32 s28, s14
    s_and_b32 s29, s15, 0xffff
    s_mov_b32 s30, 262144
    s_mov_b32 s31, 0x00020000
    s_lshl_b32 s38, s2, 10
    buffer_store_dwordx4 v[16:19], v4, s[28:31], s38 offen sc1
    s_lshr_b32 s39, s37, 1
    s_lshl_b32 s39, s39, 2
    s_and_b32 s34, s37, 1
    s_lshl_b32 s34, s34, 4
    s_lshl_b32 s33, 1, s34
    v_mov_b32 v3, s39
    v_mov_b32 v32, s33
    s_mov_b64 s[40:41], exec
    s_mov_b64 exec, 1
    global_atomic_add v33, v3, v32, s[12:13] sc0
    v_mul_u32_u24 v34, 6, v32
    s_movk_i32 s33, 1000
    s_waitcnt vmcnt(0)
    v_readfirstlane_b32 s39, v33
    s_lshr_b32 s39, s39, s34
    s_and_b32 s39, s39, 7
    s_cbranch_scc1 L_second
    global_atomic_add v3, v34, s[12:13]
    s_branch L_end
L_second:
    s_bitcmp1_b32 s39, 2
    s_cbranch_scc1 L_go
L_poll:
    s_sub_u32 s33, s33, 1
    s_cbranch_scc1 L_end
    global_load_dword v33, v3, s[12:13] sc1
    s_waitcnt vmcnt(0)
    v_readfirstlane_b32 s39, v33
    s_lshr_b32 s39, s39, s34
    s_and_b32 s39, s39, 7
    s_cbranch_scc1 L_poll
L_go:
    s_mov_b64 exec, s[40:41]
    s_lshl_b32 s38, s37, 11
    buffer_load_dwordx4 v[36:39], v4, s[28:31], s38 offen offset:0 sc1
    buffer_load_dwordx4 v[40:43], v4, s[28:31], s38 offen offset:1024 sc1
    v_and_b32 v32, 15, v1
    v_lshlrev_b32 v32, 4, v32
    v_lshrrev_b32 v33, 5, v1
    v_lshl_add_u32 v32, v33, 3, v32
    v_bfe_u32 v33, v1, 4, 1
    v_lshl_add_u32 v32, v33, 2, v32
    s_mov_b32 s28, s10
    s_and_b32 s29, s11, 0xffff
    s_mov_b32 s30, 32768
    s_lshl_b32 s38, s37, 8
    s_waitcnt vmcnt(0)
    v_max_f32 v22, v38, v42
    v_mul_f32 v3, s36, v22
    v_fma_f32 v38, v38, s35, v3
    v_fma_f32 v42, v42, s35, v3
    v_exp_f32 v38, v38
    v_exp_f32 v42, v42
    s_nop 0
    v_mul_f32 v16, v36, v38
    v_mul_f32 v17, v37, v38
    v_mul_f32 v19, v39, v38
    v_fmac_f32 v16, v40, v42
    v_fmac_f32 v17, v41, v42
    v_fmac_f32 v19, v43, v42
    v_rcp_f32 v19, v19
    s_nop 0
    v_mul_f32 v16, v16, v19
    v_mul_f32 v17, v17, v19
    v_cvt_pk_bf16_f32 v16, v16, v17
    buffer_store_dword v16, v32, s[28:31], s38 offen
L_end:
    s_endpgm
.section .rodata,"a"
.p2align 6
.amdhsa_kernel standalone__softmax_full_bidir__decode_kernel
  .amdhsa_next_free_vgpr 164
  .amdhsa_next_free_sgpr 48
  .amdhsa_accum_offset 164
  .amdhsa_group_segment_fixed_size 0
  .amdhsa_kernarg_size 48
  .amdhsa_user_sgpr_count 2
  .amdhsa_user_sgpr_kernarg_segment_ptr 1
  .amdhsa_system_sgpr_workgroup_id_x 1
.end_amdhsa_kernel
```
